```python
import torch

def _softmax(x, axis=-1):
    return torch.softmax(x, dim=axis)
def _gelu(x):
    return torch.nn.functional.gelu(x, approximate="tanh")
def _silu(x):
    return torch.nn.functional.silu(x)
def _sigmoid(x):
    return torch.sigmoid(x)
def _layernorm(x, axis=-1, eps=1e-5):
    m = x.mean(dim=axis, keepdim=True)
    v = x.var(dim=axis, keepdim=True, unbiased=False)
    return (x - m) / torch.sqrt(v + eps)
def _scatter_add(tgt, idx, src, axis=0):
    return tgt.clone().index_add_(axis, idx, src)
def _segment_sum(src, seg, n):
    out = torch.zeros((n,) + src.shape[1:], dtype=src.dtype)
    return out.index_add_(0, seg, src)
def _pad(x, pw):
    flat = tuple(v for pair in reversed(pw) for v in pair)
    return torch.nn.functional.pad(x, flat)

kernel_name = 'standalone__grn__sampling'

def setup_inputs():

    _w = (lambda a: (lambda t: t.to(torch.bfloat16) if t.is_floating_point() else t)(torch.as_tensor(a)))
    B, S, D = 1024, 8, 1024
    return {
        "x": _w((lambda *s: torch.randn(*s, dtype=torch.bfloat16) * 0.05)(B, S, D)),
        "g": _w((lambda *s: torch.randn(*s, dtype=torch.bfloat16) * 0.4)(D) * 0.1),
        "b": _w((lambda *s: torch.randn(*s, dtype=torch.bfloat16) * 0.1)(D) * 0.1),
    }

def reference(x, g, b):
    gx = torch.sqrt((x * x).sum(axis=-2, keepdims=True))
    nx = gx / (gx.mean(axis=-1, keepdims=True) + 1e-6)
    return g * (x * nx) + b + x
```

```asm
; @launch grid=(1024,1,1) block=(256,1,1) lds=64
.amdgcn_target "amdgcn-amd-amdhsa--gfx950"
.text
.globl standalone__grn__sampling_kernel
.p2align 12
.p2align 8
.type standalone__grn__sampling_kernel,@function
standalone__grn__sampling_kernel:
    s_load_dwordx8 s[4:11], s[0:1], 0
    s_cmp_ge_u32 s2, 1024
    s_cbranch_scc1 L_end
    s_lshl_b32 s3, s2, 14
    s_add_u32 s3, s3, 4096
    v_lshrrev_b32 v7, 6, v0
    v_and_b32 v1, 31, v0
    v_lshl_add_u32 v1, v7, 5, v1
    v_lshlrev_b32 v1, 4, v1
    v_bfe_u32 v3, v0, 5, 1
    v_lshl_add_u32 v2, v3, 13, v1
    v_add_u32 v2, s3, v2
    s_setprio 3
    s_waitcnt lgkmcnt(0)
    global_load_dwordx4 v[8:11], v2, s[4:5] offset:-4096
    global_load_dwordx4 v[12:15], v2, s[4:5] offset:-2048
    global_load_dwordx4 v[16:19], v2, s[4:5] offset:0
    global_load_dwordx4 v[20:23], v2, s[4:5] offset:2048
    global_load_dwordx4 v[40:43], v1, s[6:7]
    global_load_dwordx4 v[44:47], v1, s[8:9]
    s_setprio 0
    s_mov_b32 s12, 0xffff0000
    v_bfe_u32 v3, v0, 4, 2
    v_lshlrev_b32 v3, 4, v3
    v_lshl_add_u32 v3, v7, 2, v3
    v_mov_b32 v6, 0
    v_mov_b32 v7, 0x358637bd
    s_mov_b32 vcc_lo, 0
    s_mov_b32 vcc_hi, -1
    s_waitcnt vmcnt(5)
    v_lshlrev_b32 v24, 16, v8
    v_and_b32 v8, s12, v8
    v_lshlrev_b32 v25, 16, v9
    v_and_b32 v9, s12, v9
    v_lshlrev_b32 v26, 16, v10
    v_and_b32 v10, s12, v10
    v_lshlrev_b32 v27, 16, v11
    v_and_b32 v11, s12, v11
    v_pk_mul_f32 v[52:53], v[24:25], v[24:25]
    v_pk_mul_f32 v[56:57], v[8:9], v[8:9]
    v_pk_mul_f32 v[54:55], v[26:27], v[26:27]
    v_pk_mul_f32 v[58:59], v[10:11], v[10:11]
    s_waitcnt vmcnt(4)
    v_lshlrev_b32 v28, 16, v12
    v_and_b32 v12, s12, v12
    v_lshlrev_b32 v29, 16, v13
    v_and_b32 v13, s12, v13
    v_lshlrev_b32 v30, 16, v14
    v_and_b32 v14, s12, v14
    v_lshlrev_b32 v31, 16, v15
    v_and_b32 v15, s12, v15
    v_pk_fma_f32 v[52:53], v[28:29], v[28:29], v[52:53]
    v_pk_fma_f32 v[56:57], v[12:13], v[12:13], v[56:57]
    v_pk_fma_f32 v[54:55], v[30:31], v[30:31], v[54:55]
    v_pk_fma_f32 v[58:59], v[14:15], v[14:15], v[58:59]
    s_waitcnt vmcnt(3)
    v_lshlrev_b32 v32, 16, v16
    v_and_b32 v16, s12, v16
    v_lshlrev_b32 v33, 16, v17
    v_and_b32 v17, s12, v17
    v_lshlrev_b32 v34, 16, v18
    v_and_b32 v18, s12, v18
    v_lshlrev_b32 v35, 16, v19
    v_and_b32 v19, s12, v19
    v_pk_fma_f32 v[52:53], v[32:33], v[32:33], v[52:53]
    v_pk_fma_f32 v[56:57], v[16:17], v[16:17], v[56:57]
    v_pk_fma_f32 v[54:55], v[34:35], v[34:35], v[54:55]
    v_pk_fma_f32 v[58:59], v[18:19], v[18:19], v[58:59]
    s_waitcnt vmcnt(2)
    v_lshlrev_b32 v36, 16, v20
    v_and_b32 v20, s12, v20
    v_lshlrev_b32 v37, 16, v21
    v_and_b32 v21, s12, v21
    v_lshlrev_b32 v38, 16, v22
    v_and_b32 v22, s12, v22
    v_lshlrev_b32 v39, 16, v23
    v_and_b32 v23, s12, v23
    v_pk_fma_f32 v[52:53], v[36:37], v[36:37], v[52:53]
    v_pk_fma_f32 v[56:57], v[20:21], v[20:21], v[56:57]
    v_pk_fma_f32 v[54:55], v[38:39], v[38:39], v[54:55]
    v_pk_fma_f32 v[58:59], v[22:23], v[22:23], v[58:59]
    s_nop 0
    v_permlane32_swap_b32 v52, v56
    v_permlane32_swap_b32 v53, v57
    v_permlane32_swap_b32 v54, v58
    v_permlane32_swap_b32 v55, v59
    v_pk_add_f32 v[52:53], v[52:53], v[56:57]
    v_pk_add_f32 v[54:55], v[54:55], v[58:59]
    v_sqrt_f32 v52, v52
    v_sqrt_f32 v53, v53
    v_sqrt_f32 v54, v54
    v_sqrt_f32 v55, v55
    s_nop 0
    v_pk_add_f32 v[4:5], v[52:53], v[54:55]
    v_add_f32 v4, v4, v5
    s_waitcnt vmcnt(0)
    v_lshlrev_b32 v48, 16, v40
    v_add_f32_dpp v4, v4, v4 quad_perm:[1,0,3,2] row_mask:0xf bank_mask:0xf
    v_and_b32 v40, s12, v40
    v_cndmask_b32 v40, v48, v40, vcc
    v_add_f32_dpp v4, v4, v4 quad_perm:[2,3,0,1] row_mask:0xf bank_mask:0xf
    v_lshlrev_b32 v49, 16, v41
    v_and_b32 v41, s12, v41
    v_add_f32_dpp v4, v4, v4 row_half_mirror row_mask:0xf bank_mask:0xf
    v_cndmask_b32 v41, v49, v41, vcc
    v_lshlrev_b32 v50, 16, v42
    v_add_f32_dpp v4, v4, v4 row_mirror row_mask:0xf bank_mask:0xf
    v_and_b32 v42, s12, v42
    v_cndmask_b32 v42, v50, v42, vcc
    v_add_f32_dpp v4, v4, v4 row_bcast:15 row_mask:0xa bank_mask:0xf
    v_lshlrev_b32 v51, 16, v43
    v_and_b32 v43, s12, v43
    v_add_f32_dpp v4, v4, v4 row_bcast:31 row_mask:0xc bank_mask:0xf
    ds_write_b32 v3, v4
    v_cndmask_b32 v43, v51, v43, vcc
    v_lshlrev_b32 v48, 16, v44
    v_and_b32 v44, s12, v44
    v_lshlrev_b32 v49, 16, v45
    v_and_b32 v45, s12, v45
    s_waitcnt lgkmcnt(0)
    s_barrier
    ds_read_b128 v[60:63], v6 offset:48
    v_lshlrev_b32 v50, 16, v46
    v_and_b32 v46, s12, v46
    v_lshlrev_b32 v51, 16, v47
    v_and_b32 v47, s12, v47
    v_pk_mul_f32 v[52:53], v[52:53], v[40:41]
    v_pk_mul_f32 v[54:55], v[54:55], v[42:43]
    s_waitcnt lgkmcnt(0)
    v_pk_add_f32 v[4:5], v[60:61], v[62:63]
    v_add_f32 v4, v4, v5
    v_fmamk_f32 v4, v4, 0x3a800000, v7
    v_rcp_f32 v4, v4
    s_nop 0
    v_pk_fma_f32 v[56:57], v[52:53], v[4:5], 1.0 op_sel_hi:[1,0,0]
    v_pk_fma_f32 v[58:59], v[54:55], v[4:5], 1.0 op_sel_hi:[1,0,0]
    v_pk_fma_f32 v[52:53], v[52:53], v[4:5], 1.0 op_sel_hi:[1,0,0]
    v_pk_fma_f32 v[54:55], v[54:55], v[4:5], 1.0 op_sel_hi:[1,0,0]
    s_nop 0
    v_permlane32_swap_b32 v52, v56
    v_permlane32_swap_b32 v53, v57
    v_permlane32_swap_b32 v54, v58
    v_permlane32_swap_b32 v55, v59
    v_pk_fma_f32 v[24:25], v[24:25], v[52:53], v[48:49]
    v_pk_fma_f32 v[8:9], v[8:9], v[56:57], v[44:45]
    v_pk_fma_f32 v[26:27], v[26:27], v[54:55], v[50:51]
    v_pk_fma_f32 v[10:11], v[10:11], v[58:59], v[46:47]
    v_cvt_pk_bf16_f32 v8, v24, v8
    v_cvt_pk_bf16_f32 v9, v25, v9
    v_cvt_pk_bf16_f32 v10, v26, v10
    v_cvt_pk_bf16_f32 v11, v27, v11
    global_store_dwordx4 v2, v[8:11], s[10:11] offset:-4096 nt
    v_pk_fma_f32 v[28:29], v[28:29], v[52:53], v[48:49]
    v_pk_fma_f32 v[12:13], v[12:13], v[56:57], v[44:45]
    v_pk_fma_f32 v[30:31], v[30:31], v[54:55], v[50:51]
    v_pk_fma_f32 v[14:15], v[14:15], v[58:59], v[46:47]
    v_cvt_pk_bf16_f32 v12, v28, v12
    v_cvt_pk_bf16_f32 v13, v29, v13
    v_cvt_pk_bf16_f32 v14, v30, v14
    v_cvt_pk_bf16_f32 v15, v31, v15
    global_store_dwordx4 v2, v[12:15], s[10:11] offset:-2048 nt
    v_pk_fma_f32 v[32:33], v[32:33], v[52:53], v[48:49]
    v_pk_fma_f32 v[16:17], v[16:17], v[56:57], v[44:45]
    v_pk_fma_f32 v[34:35], v[34:35], v[54:55], v[50:51]
    v_pk_fma_f32 v[18:19], v[18:19], v[58:59], v[46:47]
    v_cvt_pk_bf16_f32 v16, v32, v16
    v_cvt_pk_bf16_f32 v17, v33, v17
    v_cvt_pk_bf16_f32 v18, v34, v18
    v_cvt_pk_bf16_f32 v19, v35, v19
    global_store_dwordx4 v2, v[16:19], s[10:11] offset:0 nt
    v_pk_fma_f32 v[36:37], v[36:37], v[52:53], v[48:49]
    v_pk_fma_f32 v[20:21], v[20:21], v[56:57], v[44:45]
    v_pk_fma_f32 v[38:39], v[38:39], v[54:55], v[50:51]
    v_pk_fma_f32 v[22:23], v[22:23], v[58:59], v[46:47]
    v_cvt_pk_bf16_f32 v20, v36, v20
    v_cvt_pk_bf16_f32 v21, v37, v21
    v_cvt_pk_bf16_f32 v22, v38, v22
    v_cvt_pk_bf16_f32 v23, v39, v23
    global_store_dwordx4 v2, v[20:23], s[10:11] offset:2048 nt
L_end:
    s_endpgm
.section .rodata,"a"
.p2align 6
.amdhsa_kernel standalone__grn__sampling_kernel
  .amdhsa_next_free_vgpr 64
  .amdhsa_next_free_sgpr 16
  .amdhsa_accum_offset 64
  .amdhsa_group_segment_fixed_size 0
  .amdhsa_kernarg_size 48
  .amdhsa_user_sgpr_count 2
  .amdhsa_user_sgpr_kernarg_segment_ptr 1
  .amdhsa_system_sgpr_workgroup_id_x 1
  .amdhsa_float_denorm_mode_32 3
.end_amdhsa_kernel
```
